```python
import torch

def _softmax(x, axis=-1):
    return torch.softmax(x, dim=axis)
def _gelu(x):
    return torch.nn.functional.gelu(x, approximate="tanh")
def _silu(x):
    return torch.nn.functional.silu(x)
def _sigmoid(x):
    return torch.sigmoid(x)
def _layernorm(x, axis=-1, eps=1e-5):
    m = x.mean(dim=axis, keepdim=True)
    v = x.var(dim=axis, keepdim=True, unbiased=False)
    return (x - m) / torch.sqrt(v + eps)
def _scatter_add(tgt, idx, src, axis=0):
    return tgt.clone().index_add_(axis, idx, src)
def _segment_sum(src, seg, n):
    out = torch.zeros((n,) + src.shape[1:], dtype=src.dtype)
    return out.index_add_(0, seg, src)
def _pad(x, pw):
    flat = tuple(v for pair in reversed(pw) for v in pair)
    return torch.nn.functional.pad(x, flat)

kernel_name = 'standalone__gqa_softmax__sampling'

def setup_inputs():

    _w = (lambda a: (lambda t: t.to(torch.bfloat16) if t.is_floating_point() else t)(torch.as_tensor(a)))
    B, Hq, Hkv, Sq, Sk, D = 32, 32, 4, 4, 2048, 128
    return {
        "q": _w((lambda *s: torch.randn(*s, dtype=torch.bfloat16) * 0.8)(B, Hq, Sq, D)),
        "k": _w((lambda *s: torch.randn(*s, dtype=torch.bfloat16) * 0.8)(B, Hkv, Sk, D)),
        "v": _w((lambda *s: torch.randn(*s, dtype=torch.bfloat16) * 0.05)(B, Hkv, Sk, D)),
    }

def reference(q, k, v):
    B, Hq, Sq, D = q.shape
    Hkv = k.shape[1]
    rep = Hq // Hkv
    k = (lambda x, n, axis: torch.repeat_interleave(x, n, dim=axis))(k, rep, axis=1)
    v = (lambda x, n, axis: torch.repeat_interleave(x, n, dim=axis))(v, rep, axis=1)
    scale = D ** -0.5
    scores = torch.einsum("bhqd,bhkd->bhqk", q, k) * scale
    p = _softmax(scores, axis=-1)
    return torch.einsum("bhqk,bhkd->bhqd", p, v)
```

```asm
; @launch grid=(256,1,1) block=(256,1,1) lds=138240
.amdgcn_target "amdgcn-amd-amdhsa--gfx950"
.text
.globl standalone__gqa_softmax__sampling_kernel
.p2align 8
.type standalone__gqa_softmax__sampling_kernel,@function
standalone__gqa_softmax__sampling_kernel:
  s_load_dwordx2 s[4:5], s[0:1], 8
  s_cmp_ge_u32 s2, 256
  s_cbranch_scc1 L_done
  v_lshrrev_b32 v3, 6, v0
  v_lshlrev_b32 v4, 4, v0
  v_readfirstlane_b32 s3, v3
  v_and_b32 v5, 48, v0
  s_mul_i32 s36, s2, 12800
  s_lshl_b32 s30, s2, 18
  s_and_b32 s36, s36, 0x7000
  s_or_b32 s30, s30, s36
  v_xor_b32 v1, v4, v5
  s_mul_i32 m0, s3, 8704
  s_lshl_b32 s6, 1, 26
  s_mov_b32 s7, 0x20000
  s_waitcnt lgkmcnt(0)
  buffer_load_dwordx4 v1, s[4:7], s30 offen nt lds
  s_addk_i32 m0, 1088
  s_xor_b32 s36, s30, 4096
  buffer_load_dwordx4 v1, s[4:7], s36 offen nt lds
  s_addk_i32 m0, 1088
  s_xor_b32 s36, s30, 8192
  buffer_load_dwordx4 v1, s[4:7], s36 offen nt lds
  s_addk_i32 m0, 1088
  s_xor_b32 s36, s30, 12288
  buffer_load_dwordx4 v1, s[4:7], s36 offen nt lds
  s_addk_i32 m0, 1088
  s_xor_b32 s36, s30, 16384
  buffer_load_dwordx4 v1, s[4:7], s36 offen nt lds
  s_addk_i32 m0, 1088
  s_xor_b32 s36, s30, 20480
  buffer_load_dwordx4 v1, s[4:7], s36 offen nt lds
  s_addk_i32 m0, 1088
  s_xor_b32 s36, s30, 24576
  buffer_load_dwordx4 v1, s[4:7], s36 offen nt lds
  s_addk_i32 m0, 1088
  s_xor_b32 s36, s30, 28672
  buffer_load_dwordx4 v1, s[4:7], s36 offen nt lds
  s_load_dwordx2 s[12:13], s[0:1], 0
  s_load_dwordx2 s[8:9], s[0:1], 16
  s_load_dwordx2 s[16:17], s[0:1], 24
  s_load_dwordx2 s[20:21], s[0:1], 32
  s_load_dwordx2 s[24:25], s[0:1], 40
  s_mov_b32 s31, s30
  s_add_u32 s30, s30, 0x8000
  s_mul_i32 s32, s3, 8704
  s_lshr_b32 s28, s2, 1
  s_and_b32 s29, s2, 1
  s_lshl_b32 s14, 1, 20
  s_mov_b32 s15, 0x20000
  s_mul_i32 s36, s3, 2176
  s_add_u32 m0, s36, 118784
  s_lshl_b32 s36, s28, 13
  s_lshl_b32 s37, s3, 10
  s_add_u32 s36, s36, s37
  s_waitcnt lgkmcnt(0)
  buffer_load_dwordx4 v1, s[12:15], s36 offen  lds
  s_addk_i32 m0, 64
  s_nop 0
  buffer_load_dwordx4 v1, s[12:15], s36 offen offset:1024  lds
  s_add_u32 m0, s32, 34816
  s_nop 0
  buffer_load_dwordx4 v1, s[4:7], s30 offen nt lds
  s_addk_i32 m0, 1088
  s_xor_b32 s36, s30, 4096
  buffer_load_dwordx4 v1, s[4:7], s36 offen nt lds
  s_addk_i32 m0, 1088
  s_xor_b32 s36, s30, 8192
  buffer_load_dwordx4 v1, s[4:7], s36 offen nt lds
  s_addk_i32 m0, 1088
  s_xor_b32 s36, s30, 12288
  buffer_load_dwordx4 v1, s[4:7], s36 offen nt lds
  s_addk_i32 m0, 1088
  s_xor_b32 s36, s30, 16384
  buffer_load_dwordx4 v1, s[4:7], s36 offen nt lds
  s_addk_i32 m0, 1088
  s_xor_b32 s36, s30, 20480
  buffer_load_dwordx4 v1, s[4:7], s36 offen nt lds
  s_addk_i32 m0, 1088
  s_xor_b32 s36, s30, 24576
  buffer_load_dwordx4 v1, s[4:7], s36 offen nt lds
  s_addk_i32 m0, 1088
  s_xor_b32 s36, s30, 28672
  buffer_load_dwordx4 v1, s[4:7], s36 offen nt lds
  s_add_u32 s30, s30, 0x8000
  v_lshlrev_b32 v5, 2, v5
  v_xor_b32 v2, v4, v5
  s_lshl_b32 s10, 1, 26
  s_mov_b32 s11, 0x20000
  s_movk_i32 s22, 256
  s_mov_b32 s23, 0x20000
  s_lshl_b32 s18, 1, 20
  s_mov_b32 s19, 0x20000
  s_lshl_b32 s26, 1, 23
  s_mov_b32 s27, 0x20000
  v_mov_b32 v17, 0
  v_mov_b32 v26, v4
  s_or_b32 s36, s2, s3
  s_cbranch_scc1 L_non
  s_memrealtime s[40:41]
  s_waitcnt lgkmcnt(0)
  s_mul_i32 s36, s40, 0x9E3779B1
  s_lshr_b32 s37, s36, 15
  s_xor_b32 s36, s36, s37
  s_getreg_b32 s37, hwreg(HW_REG_XCC_ID, 0, 1)
  s_andn2_b32 s36, s36, 1
  s_or_b32 s36, s36, s37
  s_cmp_lt_u32 s36, 2
  s_cselect_b32 s37, 2, 0
  s_or_b32 s36, s36, s37
  v_mov_b32 v13, s36
  buffer_store_dword v13, v17, s[20:23], 0 offen sc1
L_non:
  v_and_b32 v0, 63, v0
  v_and_b32 v100, 31, v0
  v_lshrrev_b32 v101, 5, v0
  v_lshrrev_b32 v102, 2, v100
  v_mul_u32_u24 v102, 1088, v102
  v_and_b32 v103, 3, v0
  v_lshl_add_u32 v102, v103, 8, v102
  v_xor_b32 v104, v103, v101
  v_lshl_add_u32 v105, v104, 4, v102
  v_xor_b32 v104, 2, v104
  v_lshl_add_u32 v104, v104, 4, v102
  v_add_u32 v3, s32, v105
  v_add_u32 v4, s32, v104
  v_add_u32 v76, 118784, v105
  v_add_u32 v77, 118784, v104
  v_bfe_u32 v102, v0, 2, 2
  v_lshl_add_u32 v104, v101, 2, v102
  v_lshlrev_b32 v104, 8, v104
  v_xor_b32 v102, s3, v102
  v_lshl_add_u32 v104, v102, 6, v104
  v_bfe_u32 v102, v0, 4, 1
  v_lshl_add_u32 v104, v102, 5, v104
  v_lshl_add_u32 v5, v103, 3, v104
  s_mov_b32 s37, 69632
  v_lshl_add_u32 v7, v0, 4, s37
  s_lshl_b32 s36, s3, 11
  v_add_u32 v6, s36, v7
  s_lshl_b32 s39, s28, 13
  s_add_u32 s36, s36, s39
  v_lshl_add_u32 v27, v0, 4, s36
  s_lshl_b32 s36, s3, 2
  v_and_b32 v102, 15, v0
  v_xor_b32 v103, s36, v102
  v_lshl_add_u32 v104, v100, 8, s37
  v_lshl_add_u32 v103, v103, 4, v104
  v_lshl_add_u32 v28, v101, 3, v103
  v_xor_b32 v29, 16, v28
  v_xor_b32 v30, 32, v28
  v_xor_b32 v31, 48, v28
  s_lshl_b32 s36, s3, 3
  v_lshrrev_b32 v103, 4, v0
  v_add_u32 v103, s36, v103
  v_and_b32 v104, 15, v103
  v_xor_b32 v104, v104, v102
  v_lshl_add_u32 v103, v103, 8, s37
  v_lshl_add_u32 v32, v104, 4, v103
  v_xor_b32 v33, 64, v32
  s_mov_b32 s37, 135168
  v_lshl_add_u32 v9, v100, 2, s37
  s_lshl_b32 s36, s3, 8
  s_add_u32 s36, s36, s37
  v_lshl_add_u32 v8, v0, 2, s36
  v_add_u32 v10, 2048, v8
  v_add_u32 v11, 2048, v9
  s_lshl_b32 s40, s28, 14
  s_add_u32 s41, s40, 4096
  s_add_u32 s42, s40, 8192
  v_mov_b32 v15, 0xff7fffff
  v_mov_b32 v12, 0
  v_mov_b32 v108, 0
  v_mov_b32 v109, 0
  v_mov_b32 v110, 0
  v_mov_b32 v111, 0
  v_mov_b32 v112, 0
  v_mov_b32 v113, 0
  v_mov_b32 v114, 0
  v_mov_b32 v115, 0
  v_mov_b32 v116, 0
  v_mov_b32 v117, 0
  v_mov_b32 v118, 0
  v_mov_b32 v119, 0
  v_mov_b32 v120, 0
  v_mov_b32 v121, 0
  v_mov_b32 v122, 0
  v_mov_b32 v123, 0
  s_mov_b32 s35, 0x3e0293ee
  s_mov_b32 s38, 200000
  s_mov_b32 s33, 34816
  s_mov_b32 s34, 8
  s_waitcnt vmcnt(8)
  s_barrier
  ds_read_b128 v[44:47], v76 offset:0
  ds_read_b128 v[48:51], v77 offset:0
  ds_read_b128 v[52:55], v76 offset:64
  ds_read_b128 v[56:59], v77 offset:64
  ds_read_b128 v[60:63], v76 offset:128
  ds_read_b128 v[64:67], v77 offset:128
  ds_read_b128 v[68:71], v76 offset:192
  ds_read_b128 v[72:75], v77 offset:192
  s_waitcnt lgkmcnt(4)
.p2align 6
L_k:
  s_waitcnt vmcnt(8)
  ds_read_b128 v[124:127], v3 offset:0
  ds_read_b128 v[128:131], v4 offset:0
  ds_read_b128 v[132:135], v3 offset:64
  ds_read_b128 v[136:139], v4 offset:64
  ds_read_b128 v[140:143], v3 offset:128
  ds_read_b128 v[144:147], v4 offset:128
  ds_read_b128 v[148:151], v3 offset:192
  ds_read_b128 v[152:155], v4 offset:192
  s_mov_b32 m0, s32
  s_waitcnt lgkmcnt(7)
  v_mfma_f32_32x32x16_bf16 v[76:91], v[124:127], v[44:47], 0
  s_waitcnt lgkmcnt(6)
  v_mfma_f32_32x32x16_bf16 v[76:91], v[128:131], v[48:51], v[76:91]
  s_waitcnt lgkmcnt(5)
  v_mfma_f32_32x32x16_bf16 v[76:91], v[132:135], v[52:55], v[76:91]
  s_waitcnt lgkmcnt(4)
  v_mfma_f32_32x32x16_bf16 v[76:91], v[136:139], v[56:59], v[76:91]
  s_waitcnt lgkmcnt(3)
  v_mfma_f32_32x32x16_bf16 v[76:91], v[140:143], v[60:63], v[76:91]
  s_waitcnt lgkmcnt(2)
  v_mfma_f32_32x32x16_bf16 v[76:91], v[144:147], v[64:67], v[76:91]
  s_waitcnt lgkmcnt(1)
  v_mfma_f32_32x32x16_bf16 v[76:91], v[148:151], v[68:71], v[76:91]
  s_waitcnt lgkmcnt(0)
  s_cmp_le_u32 s34, 2
  s_cbranch_scc1 L_kv
  buffer_load_dwordx4 v1, s[4:7], s30 offen nt lds
  s_addk_i32 m0, 1088
  s_xor_b32 s36, s30, 4096
  buffer_load_dwordx4 v1, s[4:7], s36 offen nt lds
  s_addk_i32 m0, 1088
  s_xor_b32 s36, s30, 8192
  buffer_load_dwordx4 v1, s[4:7], s36 offen nt lds
  s_addk_i32 m0, 1088
  s_xor_b32 s36, s30, 12288
  buffer_load_dwordx4 v1, s[4:7], s36 offen nt lds
  s_addk_i32 m0, 1088
  s_xor_b32 s36, s30, 16384
  buffer_load_dwordx4 v1, s[4:7], s36 offen nt lds
  s_addk_i32 m0, 1088
  s_xor_b32 s36, s30, 20480
  buffer_load_dwordx4 v1, s[4:7], s36 offen nt lds
  s_addk_i32 m0, 1088
  s_xor_b32 s36, s30, 24576
  buffer_load_dwordx4 v1, s[4:7], s36 offen nt lds
  s_addk_i32 m0, 1088
  s_xor_b32 s36, s30, 28672
  buffer_load_dwordx4 v1, s[4:7], s36 offen nt lds
  s_add_u32 s30, s30, 0x8000
L_kr:
  v_mfma_f32_32x32x16_bf16 v[76:91], v[152:155], v[72:75], v[76:91]
  v_add_u32 v3, s33, v3
  v_add_u32 v4, s33, v4
  s_add_u32 s32, s32, s33
  s_sub_u32 s33, 0, s33
  v_mov_b32 v34, v15
  s_nop 6
  v_max3_f32 v13, v76, v77, v78
  v_max3_f32 v14, v79, v80, v81
  v_max3_f32 v13, v13, v82, v83
  v_max3_f32 v14, v14, v84, v85
  v_max3_f32 v13, v13, v86, v87
  v_max3_f32 v14, v14, v88, v89
  v_max3_f32 v13, v13, v90, v91
  v_max_f32 v13, v13, v14
  v_mul_f32 v13, s35, v13
  ds_write_b32 v8, v13
  v_xor_b32 v8, 0x400, v8
  s_waitcnt lgkmcnt(0)
  s_barrier
  ds_read2_b32 v[100:101], v9 offset0:0 offset1:32
  ds_read2_b32 v[102:103], v9 offset0:64 offset1:96
  ds_read2_b32 v[104:105], v9 offset0:128 offset1:160
  ds_read2_b32 v[106:107], v9 offset0:192 offset1:224
  v_xor_b32 v9, 0x400, v9
  s_waitcnt lgkmcnt(0)
  v_max3_f32 v13, v100, v101, v102
  v_max3_f32 v14, v103, v104, v105
  v_max3_f32 v13, v13, v106, v107
  v_max3_f32 v15, v13, v14, v34
  v_sub_f32 v34, v34, v15
  v_fma_f32 v76, v76, s35, -v15
  v_fma_f32 v77, v77, s35, -v15
  v_fma_f32 v78, v78, s35, -v15
  v_fma_f32 v79, v79, s35, -v15
  v_fma_f32 v80, v80, s35, -v15
  v_fma_f32 v81, v81, s35, -v15
  v_fma_f32 v82, v82, s35, -v15
  v_fma_f32 v83, v83, s35, -v15
  v_fma_f32 v84, v84, s35, -v15
  v_fma_f32 v85, v85, s35, -v15
  v_fma_f32 v86, v86, s35, -v15
  v_fma_f32 v87, v87, s35, -v15
  v_fma_f32 v88, v88, s35, -v15
  v_fma_f32 v89, v89, s35, -v15
  v_fma_f32 v90, v90, s35, -v15
  v_fma_f32 v91, v91, s35, -v15
  v_exp_f32 v34, v34
  v_exp_f32 v76, v76
  v_exp_f32 v77, v77
  v_exp_f32 v78, v78
  v_exp_f32 v79, v79
  v_exp_f32 v80, v80
  v_exp_f32 v81, v81
  v_exp_f32 v82, v82
  v_exp_f32 v83, v83
  v_exp_f32 v84, v84
  v_exp_f32 v85, v85
  v_exp_f32 v86, v86
  v_exp_f32 v87, v87
  v_exp_f32 v88, v88
  v_exp_f32 v89, v89
  v_exp_f32 v90, v90
  v_exp_f32 v91, v91
  v_mul_f32 v12, v12, v34
  v_cvt_pk_bf16_f32 v92, v76, v77
  v_cvt_pk_bf16_f32 v93, v78, v79
  v_cvt_pk_bf16_f32 v94, v80, v81
  v_cvt_pk_bf16_f32 v95, v82, v83
  v_cvt_pk_bf16_f32 v96, v84, v85
  v_cvt_pk_bf16_f32 v97, v86, v87
  v_cvt_pk_bf16_f32 v98, v88, v89
  v_cvt_pk_bf16_f32 v99, v90, v91
  ds_write_b128 v6, v[92:95]
  ds_write_b128 v6, v[96:99] offset:1024
  v_add_u32 v6, 0x2000, v6
  v_pk_add_f32 v[100:101], v[76:77], v[84:85]
  v_pk_add_f32 v[102:103], v[78:79], v[86:87]
  v_pk_add_f32 v[104:105], v[80:81], v[88:89]
  v_pk_add_f32 v[106:107], v[82:83], v[90:91]
  v_pk_add_f32 v[100:101], v[100:101], v[104:105]
  v_pk_add_f32 v[102:103], v[102:103], v[106:107]
  v_pk_add_f32 v[100:101], v[100:101], v[102:103]
  v_mov_b32 v42, v41
  v_mov_b32 v41, v40
  v_mov_b32 v40, v39
  v_mov_b32 v39, v38
  v_mov_b32 v38, v37
  v_mov_b32 v37, v36
  v_mov_b32 v36, v35
  v_mov_b32 v35, v34
  v_add_f32 v12, v12, v100
  v_add_f32 v12, v12, v101
  s_sub_u32 s34, s34, 1
  s_cmp_lg_u32 s34, 0
  s_cbranch_scc1 L_k
  ds_write_b32 v10, v12
  s_mov_b32 s34, 7
  s_branch L_v
L_kv:
  s_cmp_eq_u32 s34, 1
  s_cbranch_scc1 L_kv1
  buffer_load_dword v22, v17, s[20:23], 0 offen sc1
L_kv1:
  buffer_load_dwordx4 v2, s[8:11], s31 offen nt lds
  s_addk_i32 m0, 1024
  s_xor_b32 s36, s31, 4096
  buffer_load_dwordx4 v2, s[8:11], s36 offen nt lds
  s_addk_i32 m0, 1024
  s_xor_b32 s36, s31, 8192
  buffer_load_dwordx4 v2, s[8:11], s36 offen nt lds
  s_addk_i32 m0, 1024
  s_xor_b32 s36, s31, 12288
  buffer_load_dwordx4 v2, s[8:11], s36 offen nt lds
  s_addk_i32 m0, 1024
  s_xor_b32 s36, s31, 16384
  buffer_load_dwordx4 v2, s[8:11], s36 offen nt lds
  s_addk_i32 m0, 1024
  s_xor_b32 s36, s31, 20480
  buffer_load_dwordx4 v2, s[8:11], s36 offen nt lds
  s_addk_i32 m0, 1024
  s_xor_b32 s36, s31, 24576
  buffer_load_dwordx4 v2, s[8:11], s36 offen nt lds
  s_addk_i32 m0, 1024
  s_xor_b32 s36, s31, 28672
  buffer_load_dwordx4 v2, s[8:11], s36 offen nt lds
  s_add_u32 s31, s31, 0x8000
  s_branch L_kr
L_side:
  s_cmp_eq_u32 s34, 5
  s_cbranch_scc1 L_p7
  ds_read2_b32 v[100:101], v11 offset0:0 offset1:32
  ds_read2_b32 v[102:103], v11 offset0:64 offset1:96
  ds_read2_b32 v[104:105], v11 offset0:128 offset1:160
  ds_read2_b32 v[106:107], v11 offset0:192 offset1:224
  v_and_b32 v14, 3, v0
  v_lshlrev_b32 v14, 3, v14
  s_mov_b32 s39, 0xfffff000
L_npoll:
  v_cmp_eq_u32 vcc, 0, v22
  s_cbranch_vccz L_nok
  s_sub_u32 s38, s38, 1
  s_cbranch_scc1 L_nok
  buffer_load_dword v22, v17, s[20:23], 0 offen sc1
  s_waitcnt vmcnt(0)
  s_branch L_npoll
L_nok:
  v_readfirstlane_b32 s36, v22
  v_lshrrev_b32 v22, v14, v22
  v_lshrrev_b32 v13, 2, v0
  v_xor_b32 v22, v22, v13
  s_and_b32 s36, s36, 1
  s_xor_b32 s29, s29, s36
  v_bfe_u32 v23, v22, 4, 4
  v_and_b32 v22, 15, v22
  v_subrev_u32 v6, 0x2000, v6
  s_waitcnt lgkmcnt(0)
  v_pk_add_f32 v[100:101], v[100:101], v[104:105]
  v_pk_add_f32 v[102:103], v[102:103], v[106:107]
  v_pk_add_f32 v[100:101], v[100:101], v[102:103]
  v_add_f32 v100, v100, v101
  v_rcp_f32 v18, v100
  v_log_f32 v16, v100
  v_pk_mul_f32 v[76:77], v[76:77], v[18:19] op_sel_hi:[1,0]
  v_pk_mul_f32 v[78:79], v[78:79], v[18:19] op_sel_hi:[1,0]
  v_pk_mul_f32 v[80:81], v[80:81], v[18:19] op_sel_hi:[1,0]
  v_pk_mul_f32 v[82:83], v[82:83], v[18:19] op_sel_hi:[1,0]
  v_pk_mul_f32 v[84:85], v[84:85], v[18:19] op_sel_hi:[1,0]
  v_pk_mul_f32 v[86:87], v[86:87], v[18:19] op_sel_hi:[1,0]
  v_pk_mul_f32 v[88:89], v[88:89], v[18:19] op_sel_hi:[1,0]
  v_pk_mul_f32 v[90:91], v[90:91], v[18:19] op_sel_hi:[1,0]
  v_cvt_pk_bf16_f32 v92, v76, v77
  v_cvt_pk_bf16_f32 v93, v78, v79
  v_cvt_pk_bf16_f32 v94, v80, v81
  v_cvt_pk_bf16_f32 v95, v82, v83
  v_cvt_pk_bf16_f32 v96, v84, v85
  v_cvt_pk_bf16_f32 v97, v86, v87
  v_cvt_pk_bf16_f32 v98, v88, v89
  v_cvt_pk_bf16_f32 v99, v90, v91
  ds_write_b128 v6, v[92:95]
  ds_write_b128 v6, v[96:99] offset:1024
  v_mul_f32 v36, v36, v18
  v_add_f32 v16, v16, v15
  v_and_b32 v24, s39, v16
  v_sub_f32 v25, v16, v24
  v_and_b32 v25, s39, v25
  s_branch L_v
L_p7:
  ds_read_b128 v[44:47], v7 offset:40960
  ds_read_b128 v[48:51], v7 offset:41984
  ds_read_b128 v[52:55], v7 offset:43008
  ds_read_b128 v[56:59], v7 offset:44032
  ds_read_b128 v[60:63], v7 offset:45056
  ds_read_b128 v[64:67], v7 offset:46080
  ds_read_b128 v[68:71], v7 offset:47104
  ds_read_b128 v[72:75], v7 offset:48128
  s_waitcnt lgkmcnt(4)
.p2align 6
L_v:
  ds_read_b128 v[156:159], v7 offset:0
  ds_read_b128 v[160:163], v7 offset:1024
  ds_read_b128 v[164:167], v7 offset:2048
  ds_read_b128 v[168:171], v7 offset:3072
  ds_read_b128 v[172:175], v7 offset:4096
  ds_read_b128 v[176:179], v7 offset:5120
  ds_read_b128 v[180:183], v7 offset:6144
  ds_read_b128 v[184:187], v7 offset:7168
  v_add_u32 v7, 0x2000, v7
  s_nop 2
  v_pk_mul_f32 v[108:109], v[108:109], v[42:43] op_sel_hi:[1,0]
  v_pk_mul_f32 v[110:111], v[110:111], v[42:43] op_sel_hi:[1,0]
  v_pk_mul_f32 v[112:113], v[112:113], v[42:43] op_sel_hi:[1,0]
  v_pk_mul_f32 v[114:115], v[114:115], v[42:43] op_sel_hi:[1,0]
  v_pk_mul_f32 v[116:117], v[116:117], v[42:43] op_sel_hi:[1,0]
  v_pk_mul_f32 v[118:119], v[118:119], v[42:43] op_sel_hi:[1,0]
  v_pk_mul_f32 v[120:121], v[120:121], v[42:43] op_sel_hi:[1,0]
  v_pk_mul_f32 v[122:123], v[122:123], v[42:43] op_sel_hi:[1,0]
  v_mov_b32 v42, v41
  v_mov_b32 v41, v40
  v_mov_b32 v40, v39
  v_mov_b32 v39, v38
  v_mov_b32 v38, v37
  v_mov_b32 v37, v36
  v_mov_b32 v36, v35
  v_mov_b32 v35, v34
  s_waitcnt vmcnt(8) lgkmcnt(0)
  s_barrier
  ds_read_b64_tr_b16 v[124:125], v5 offset:0
  ds_read_b64_tr_b16 v[126:127], v5 offset:2048
  ds_read_b64_tr_b16 v[128:129], v5 offset:8704
  ds_read_b64_tr_b16 v[130:131], v5 offset:10752
  ds_read_b64_tr_b16 v[132:133], v5 offset:17408
  ds_read_b64_tr_b16 v[134:135], v5 offset:19456
  ds_read_b64_tr_b16 v[136:137], v5 offset:26112
  ds_read_b64_tr_b16 v[138:139], v5 offset:28160
  ds_read_b64_tr_b16 v[140:141], v5 offset:4096
  ds_read_b64_tr_b16 v[142:143], v5 offset:6144
  ds_read_b64_tr_b16 v[144:145], v5 offset:12800
  ds_read_b64_tr_b16 v[146:147], v5 offset:14848
  ds_read_b64_tr_b16 v[148:149], v5 offset:21504
  ds_read_b64_tr_b16 v[150:151], v5 offset:23552
  s_waitcnt lgkmcnt(12)
  ds_read_b64_tr_b16 v[152:153], v5 offset:30208
  ds_read_b64_tr_b16 v[154:155], v5 offset:32256
  v_add_u32 v5, s33, v5
  s_sub_u32 s34, s34, 1
  s_cmp_eq_u32 s34, 0
  s_cbranch_scc1 L_last
  s_mov_b32 m0, s32
  s_waitcnt lgkmcnt(0)
  s_barrier
  buffer_load_dwordx4 v2, s[8:11], s31 offen nt lds
  s_addk_i32 m0, 1024
  s_xor_b32 s36, s31, 4096
  buffer_load_dwordx4 v2, s[8:11], s36 offen nt lds
  s_addk_i32 m0, 1024
  s_xor_b32 s36, s31, 8192
  buffer_load_dwordx4 v2, s[8:11], s36 offen nt lds
  s_addk_i32 m0, 1024
  s_xor_b32 s36, s31, 12288
  buffer_load_dwordx4 v2, s[8:11], s36 offen nt lds
  s_addk_i32 m0, 1024
  s_xor_b32 s36, s31, 16384
  buffer_load_dwordx4 v2, s[8:11], s36 offen nt lds
  s_addk_i32 m0, 1024
  s_xor_b32 s36, s31, 20480
  buffer_load_dwordx4 v2, s[8:11], s36 offen nt lds
  s_addk_i32 m0, 1024
  s_xor_b32 s36, s31, 24576
  buffer_load_dwordx4 v2, s[8:11], s36 offen nt lds
  s_addk_i32 m0, 1024
  s_xor_b32 s36, s31, 28672
  buffer_load_dwordx4 v2, s[8:11], s36 offen nt lds
  s_add_u32 s31, s31, 0x8000
  s_add_u32 s32, s32, s33
  s_sub_u32 s33, 0, s33
  v_mfma_f32_32x32x16_bf16 v[108:123], v[124:127], v[156:159], v[108:123]
  v_mfma_f32_32x32x16_bf16 v[108:123], v[128:131], v[164:167], v[108:123]
  v_mfma_f32_32x32x16_bf16 v[108:123], v[132:135], v[172:175], v[108:123]
  v_mfma_f32_32x32x16_bf16 v[108:123], v[136:139], v[180:183], v[108:123]
  v_mfma_f32_32x32x16_bf16 v[108:123], v[140:143], v[160:163], v[108:123]
  v_mfma_f32_32x32x16_bf16 v[108:123], v[144:147], v[168:171], v[108:123]
  v_mfma_f32_32x32x16_bf16 v[108:123], v[148:151], v[176:179], v[108:123]
  v_mfma_f32_32x32x16_bf16 v[108:123], v[152:155], v[184:187], v[108:123]
  s_cmp_ge_u32 s34, 5
  s_cbranch_scc1 L_side
  s_branch L_v
L_last:
  s_waitcnt lgkmcnt(14)
  v_mfma_f32_32x32x16_bf16 v[108:123], v[124:127], v[156:159], v[108:123]
  s_waitcnt lgkmcnt(12)
  v_mfma_f32_32x32x16_bf16 v[108:123], v[128:131], v[164:167], v[108:123]
  s_waitcnt lgkmcnt(10)
  v_mfma_f32_32x32x16_bf16 v[108:123], v[132:135], v[172:175], v[108:123]
  s_waitcnt lgkmcnt(8)
  v_mfma_f32_32x32x16_bf16 v[108:123], v[136:139], v[180:183], v[108:123]
  s_waitcnt lgkmcnt(6)
  v_mfma_f32_32x32x16_bf16 v[108:123], v[140:143], v[160:163], v[108:123]
  s_waitcnt lgkmcnt(4)
  v_mfma_f32_32x32x16_bf16 v[108:123], v[144:147], v[168:171], v[108:123]
  s_waitcnt lgkmcnt(2)
  v_mfma_f32_32x32x16_bf16 v[108:123], v[148:151], v[176:179], v[108:123]
  s_waitcnt lgkmcnt(0)
  v_mfma_f32_32x32x16_bf16 v[108:123], v[152:155], v[184:187], v[108:123]
  s_cmp_eq_u32 s29, 1
  s_cbranch_scc1 L_fin
  s_waitcnt vmcnt(4)
  s_barrier
  ds_read_b64_tr_b16 v[124:125], v5 offset:0
  ds_read_b64_tr_b16 v[126:127], v5 offset:2048
  ds_read_b64_tr_b16 v[128:129], v5 offset:8704
  ds_read_b64_tr_b16 v[130:131], v5 offset:10752
  ds_read_b64_tr_b16 v[132:133], v5 offset:17408
  ds_read_b64_tr_b16 v[134:135], v5 offset:19456
  ds_read_b64_tr_b16 v[136:137], v5 offset:26112
  ds_read_b64_tr_b16 v[138:139], v5 offset:28160
  v_pk_mul_f32 v[108:109], v[108:109], v[42:43] op_sel_hi:[1,0]
  v_pk_mul_f32 v[110:111], v[110:111], v[42:43] op_sel_hi:[1,0]
  v_pk_mul_f32 v[112:113], v[112:113], v[42:43] op_sel_hi:[1,0]
  v_pk_mul_f32 v[114:115], v[114:115], v[42:43] op_sel_hi:[1,0]
  v_pk_mul_f32 v[116:117], v[116:117], v[42:43] op_sel_hi:[1,0]
  v_pk_mul_f32 v[118:119], v[118:119], v[42:43] op_sel_hi:[1,0]
  v_pk_mul_f32 v[120:121], v[120:121], v[42:43] op_sel_hi:[1,0]
  v_pk_mul_f32 v[122:123], v[122:123], v[42:43] op_sel_hi:[1,0]
  s_nop 0
  s_waitcnt lgkmcnt(6)
  v_mfma_f32_32x32x16_bf16 v[108:123], v[124:127], v[44:47], v[108:123]
  s_waitcnt lgkmcnt(4)
  v_mfma_f32_32x32x16_bf16 v[108:123], v[128:131], v[52:55], v[108:123]
  s_waitcnt lgkmcnt(2)
  v_mfma_f32_32x32x16_bf16 v[108:123], v[132:135], v[60:63], v[108:123]
  s_waitcnt lgkmcnt(0)
  v_mfma_f32_32x32x16_bf16 v[108:123], v[136:139], v[68:71], v[108:123]
  s_waitcnt vmcnt(0)
  s_barrier
  ds_read_b64_tr_b16 v[140:141], v5 offset:4096
  ds_read_b64_tr_b16 v[142:143], v5 offset:6144
  ds_read_b64_tr_b16 v[144:145], v5 offset:12800
  ds_read_b64_tr_b16 v[146:147], v5 offset:14848
  ds_read_b64_tr_b16 v[148:149], v5 offset:21504
  ds_read_b64_tr_b16 v[150:151], v5 offset:23552
  ds_read_b64_tr_b16 v[152:153], v5 offset:30208
  ds_read_b64_tr_b16 v[154:155], v5 offset:32256
  s_waitcnt lgkmcnt(6)
  v_mfma_f32_32x32x16_bf16 v[108:123], v[140:143], v[48:51], v[108:123]
  s_waitcnt lgkmcnt(4)
  v_mfma_f32_32x32x16_bf16 v[108:123], v[144:147], v[56:59], v[108:123]
  s_waitcnt lgkmcnt(2)
  v_mfma_f32_32x32x16_bf16 v[108:123], v[148:151], v[64:67], v[108:123]
  s_waitcnt lgkmcnt(0)
  v_mfma_f32_32x32x16_bf16 v[108:123], v[152:155], v[72:75], v[108:123]
  v_lshrrev_b32 v196, 20, v24
  v_bfe_u32 v197, v24, 12, 8
  v_lshl_or_b32 v197, v197, 4, v22
  v_lshrrev_b32 v198, 20, v25
  v_bfe_u32 v199, v25, 12, 8
  v_lshl_or_b32 v199, v199, 4, v23
  s_nop 5
  v_and_or_b32 v196, v108, s39, v196
  v_and_or_b32 v197, v109, s39, v197
  v_and_or_b32 v198, v110, s39, v198
  v_and_or_b32 v199, v111, s39, v199
  buffer_store_dwordx4 v[196:199], v26, s[24:27], s42 offen sc1
  v_lshrrev_b32 v188, 20, v116
  v_bfe_u32 v189, v116, 12, 8
  v_lshl_or_b32 v189, v189, 4, v22
  v_lshrrev_b32 v190, 20, v117
  v_bfe_u32 v191, v117, 12, 8
  v_lshl_or_b32 v191, v191, 4, v23
  v_and_or_b32 v188, v112, s39, v188
  v_and_or_b32 v189, v113, s39, v189
  v_and_or_b32 v190, v114, s39, v190
  v_and_or_b32 v191, v115, s39, v191
  buffer_store_dwordx4 v[188:191], v26, s[24:27], s40 offen sc1
  v_lshrrev_b32 v192, 20, v122
  v_bfe_u32 v193, v122, 12, 8
  v_lshl_or_b32 v193, v193, 4, v22
  v_lshrrev_b32 v194, 20, v123
  v_bfe_u32 v195, v123, 12, 8
  v_lshl_or_b32 v195, v195, 4, v23
  v_and_or_b32 v192, v118, s39, v192
  v_and_or_b32 v193, v119, s39, v193
  v_and_or_b32 v194, v120, s39, v194
  v_and_or_b32 v195, v121, s39, v195
  buffer_store_dwordx4 v[192:195], v26, s[24:27], s41 offen sc1
  s_endpgm
L_fin:
  buffer_load_dwordx4 v[196:199], v26, s[24:27], s42 offen sc1
  buffer_load_dwordx4 v[188:191], v26, s[24:27], s40 offen sc1
  buffer_load_dwordx4 v[192:195], v26, s[24:27], s41 offen sc1
  s_waitcnt vmcnt(7)
  s_barrier
  ds_read_b64_tr_b16 v[124:125], v5 offset:0
  ds_read_b64_tr_b16 v[126:127], v5 offset:2048
  ds_read_b64_tr_b16 v[128:129], v5 offset:8704
  ds_read_b64_tr_b16 v[130:131], v5 offset:10752
  ds_read_b64_tr_b16 v[132:133], v5 offset:17408
  ds_read_b64_tr_b16 v[134:135], v5 offset:19456
  ds_read_b64_tr_b16 v[136:137], v5 offset:26112
  ds_read_b64_tr_b16 v[138:139], v5 offset:28160
  v_pk_mul_f32 v[108:109], v[108:109], v[42:43] op_sel_hi:[1,0]
  v_pk_mul_f32 v[110:111], v[110:111], v[42:43] op_sel_hi:[1,0]
  v_pk_mul_f32 v[112:113], v[112:113], v[42:43] op_sel_hi:[1,0]
  v_pk_mul_f32 v[114:115], v[114:115], v[42:43] op_sel_hi:[1,0]
  v_pk_mul_f32 v[116:117], v[116:117], v[42:43] op_sel_hi:[1,0]
  v_pk_mul_f32 v[118:119], v[118:119], v[42:43] op_sel_hi:[1,0]
  v_pk_mul_f32 v[120:121], v[120:121], v[42:43] op_sel_hi:[1,0]
  v_pk_mul_f32 v[122:123], v[122:123], v[42:43] op_sel_hi:[1,0]
  s_nop 0
  s_waitcnt lgkmcnt(6)
  v_mfma_f32_32x32x16_bf16 v[108:123], v[124:127], v[44:47], v[108:123]
  s_waitcnt lgkmcnt(4)
  v_mfma_f32_32x32x16_bf16 v[108:123], v[128:131], v[52:55], v[108:123]
  s_waitcnt lgkmcnt(2)
  v_mfma_f32_32x32x16_bf16 v[108:123], v[132:135], v[60:63], v[108:123]
  s_waitcnt lgkmcnt(0)
  v_mfma_f32_32x32x16_bf16 v[108:123], v[136:139], v[68:71], v[108:123]
  s_waitcnt vmcnt(3)
  s_barrier
  ds_read_b64_tr_b16 v[140:141], v5 offset:4096
  ds_read_b64_tr_b16 v[142:143], v5 offset:6144
  ds_read_b64_tr_b16 v[144:145], v5 offset:12800
  ds_read_b64_tr_b16 v[146:147], v5 offset:14848
  ds_read_b64_tr_b16 v[148:149], v5 offset:21504
  ds_read_b64_tr_b16 v[150:151], v5 offset:23552
  ds_read_b64_tr_b16 v[152:153], v5 offset:30208
  ds_read_b64_tr_b16 v[154:155], v5 offset:32256
  s_waitcnt lgkmcnt(6)
  v_mfma_f32_32x32x16_bf16 v[108:123], v[140:143], v[48:51], v[108:123]
  s_waitcnt vmcnt(0)
  v_xor_b32 v100, v189, v22
  v_xor_b32 v101, v191, v23
  v_xor_b32 v102, v193, v22
  v_xor_b32 v103, v195, v23
  v_xor_b32 v104, v197, v22
  v_xor_b32 v105, v199, v23
  v_or3_b32 v100, v100, v101, v102
  v_or3_b32 v103, v103, v104, v105
  v_or_b32 v100, v100, v103
  v_and_b32 v100, 15, v100
  v_cmp_ne_u32 vcc, 0, v100
  s_cbranch_vccnz L_retry
  s_waitcnt lgkmcnt(4)
  v_mfma_f32_32x32x16_bf16 v[108:123], v[144:147], v[56:59], v[108:123]
  v_bfe_u32 v172, v197, 4, 8
  v_lshlrev_b32 v172, 12, v172
  v_lshl_or_b32 v172, v196, 20, v172
  v_bfe_u32 v173, v199, 4, 8
  v_lshlrev_b32 v173, 12, v173
  v_lshl_or_b32 v173, v198, 20, v173
  v_sub_f32 v20, v24, v172
  s_waitcnt lgkmcnt(2)
  v_mfma_f32_32x32x16_bf16 v[108:123], v[148:151], v[64:67], v[108:123]
  v_sub_f32 v18, v25, v173
  v_and_b32 v156, s39, v196
  v_add_f32 v20, v20, v18
  v_and_b32 v157, s39, v197
  v_exp_f32 v18, -v20
  v_exp_f32 v20, v20
  v_and_b32 v158, s39, v198
  s_waitcnt lgkmcnt(0)
  v_mfma_f32_32x32x16_bf16 v[108:123], v[152:155], v[72:75], v[108:123]
  v_and_b32 v159, s39, v199
  v_add_f32 v18, 1.0, v18
  v_add_f32 v20, 1.0, v20
  v_rcp_f32 v18, v18
  v_rcp_f32 v20, v20
  v_bfe_u32 v164, v189, 4, 8
  v_lshlrev_b32 v164, 12, v164
  v_lshl_or_b32 v164, v188, 20, v164
  v_bfe_u32 v165, v191, 4, 8
  v_lshlrev_b32 v165, 12, v165
  v_lshl_or_b32 v165, v190, 20, v165
  v_and_b32 v160, s39, v188
  v_and_b32 v161, s39, v189
  v_and_b32 v162, s39, v190
  v_and_b32 v163, s39, v191
  v_bfe_u32 v170, v193, 4, 8
  v_lshlrev_b32 v170, 12, v170
  v_lshl_or_b32 v170, v192, 20, v170
  v_bfe_u32 v171, v195, 4, 8
  v_lshlrev_b32 v171, 12, v171
  v_lshl_or_b32 v171, v194, 20, v171
  v_and_b32 v166, s39, v192
  v_and_b32 v167, s39, v193
  v_and_b32 v168, s39, v194
  v_and_b32 v169, s39, v195
  v_pk_mul_f32 v[156:157], v[156:157], v[20:21] op_sel_hi:[1,0]
  v_pk_mul_f32 v[158:159], v[158:159], v[20:21] op_sel_hi:[1,0]
  v_pk_mul_f32 v[160:161], v[160:161], v[20:21] op_sel_hi:[1,0]
  v_pk_mul_f32 v[162:163], v[162:163], v[20:21] op_sel_hi:[1,0]
  v_pk_mul_f32 v[164:165], v[164:165], v[20:21] op_sel_hi:[1,0]
  v_pk_mul_f32 v[166:167], v[166:167], v[20:21] op_sel_hi:[1,0]
  v_pk_mul_f32 v[168:169], v[168:169], v[20:21] op_sel_hi:[1,0]
  v_pk_mul_f32 v[170:171], v[170:171], v[20:21] op_sel_hi:[1,0]
  s_branch L_got
L_retry:
  buffer_load_dwordx4 v[196:199], v26, s[24:27], s42 offen sc1
  buffer_load_dwordx4 v[188:191], v26, s[24:27], s40 offen sc1
  buffer_load_dwordx4 v[192:195], v26, s[24:27], s41 offen sc1
  s_waitcnt lgkmcnt(4)
  v_mfma_f32_32x32x16_bf16 v[108:123], v[144:147], v[56:59], v[108:123]
  s_waitcnt lgkmcnt(2)
  v_mfma_f32_32x32x16_bf16 v[108:123], v[148:151], v[64:67], v[108:123]
  s_waitcnt lgkmcnt(0)
  v_mfma_f32_32x32x16_bf16 v[108:123], v[152:155], v[72:75], v[108:123]
L_poll:
  s_waitcnt vmcnt(0)
  v_xor_b32 v100, v189, v22
  v_xor_b32 v101, v191, v23
  v_xor_b32 v102, v193, v22
  v_xor_b32 v103, v195, v23
  v_xor_b32 v104, v197, v22
  v_xor_b32 v105, v199, v23
  v_or3_b32 v100, v100, v101, v102
  v_or3_b32 v103, v103, v104, v105
  v_or_b32 v100, v100, v103
  v_and_b32 v100, 15, v100
  v_cmp_ne_u32 vcc, 0, v100
  s_cbranch_vccz L_unpack
  s_sub_u32 s38, s38, 1
  s_cbranch_scc1 L_unpack
  buffer_load_dwordx4 v[196:199], v26, s[24:27], s42 offen sc1
  buffer_load_dwordx4 v[188:191], v26, s[24:27], s40 offen sc1
  buffer_load_dwordx4 v[192:195], v26, s[24:27], s41 offen sc1
  s_branch L_poll
L_unpack:
  v_bfe_u32 v172, v197, 4, 8
  v_lshlrev_b32 v172, 12, v172
  v_lshl_or_b32 v172, v196, 20, v172
  v_bfe_u32 v173, v199, 4, 8
  v_lshlrev_b32 v173, 12, v173
  v_lshl_or_b32 v173, v198, 20, v173
  v_sub_f32 v20, v24, v172
  v_sub_f32 v18, v25, v173
  v_and_b32 v156, s39, v196
  v_add_f32 v20, v20, v18
  v_and_b32 v157, s39, v197
  v_exp_f32 v18, -v20
  v_exp_f32 v20, v20
  v_and_b32 v158, s39, v198
  v_and_b32 v159, s39, v199
  v_add_f32 v18, 1.0, v18
  v_add_f32 v20, 1.0, v20
  v_rcp_f32 v18, v18
  v_rcp_f32 v20, v20
  v_bfe_u32 v164, v189, 4, 8
  v_lshlrev_b32 v164, 12, v164
  v_lshl_or_b32 v164, v188, 20, v164
  v_bfe_u32 v165, v191, 4, 8
  v_lshlrev_b32 v165, 12, v165
  v_lshl_or_b32 v165, v190, 20, v165
  v_and_b32 v160, s39, v188
  v_and_b32 v161, s39, v189
  v_and_b32 v162, s39, v190
  v_and_b32 v163, s39, v191
  v_bfe_u32 v170, v193, 4, 8
  v_lshlrev_b32 v170, 12, v170
  v_lshl_or_b32 v170, v192, 20, v170
  v_bfe_u32 v171, v195, 4, 8
  v_lshlrev_b32 v171, 12, v171
  v_lshl_or_b32 v171, v194, 20, v171
  v_and_b32 v166, s39, v192
  v_and_b32 v167, s39, v193
  v_and_b32 v168, s39, v194
  v_and_b32 v169, s39, v195
  v_pk_mul_f32 v[156:157], v[156:157], v[20:21] op_sel_hi:[1,0]
  v_pk_mul_f32 v[158:159], v[158:159], v[20:21] op_sel_hi:[1,0]
  v_pk_mul_f32 v[160:161], v[160:161], v[20:21] op_sel_hi:[1,0]
  v_pk_mul_f32 v[162:163], v[162:163], v[20:21] op_sel_hi:[1,0]
  v_pk_mul_f32 v[164:165], v[164:165], v[20:21] op_sel_hi:[1,0]
  v_pk_mul_f32 v[166:167], v[166:167], v[20:21] op_sel_hi:[1,0]
  v_pk_mul_f32 v[168:169], v[168:169], v[20:21] op_sel_hi:[1,0]
  v_pk_mul_f32 v[170:171], v[170:171], v[20:21] op_sel_hi:[1,0]
L_got:
  v_and_b32 v108, s39, v108
  v_and_b32 v109, s39, v109
  v_and_b32 v110, s39, v110
  v_and_b32 v111, s39, v111
  v_and_b32 v112, s39, v112
  v_and_b32 v113, s39, v113
  v_and_b32 v114, s39, v114
  v_and_b32 v115, s39, v115
  v_pk_mul_f32 v[108:109], v[108:109], v[18:19] op_sel_hi:[1,0]
  v_pk_mul_f32 v[110:111], v[110:111], v[18:19] op_sel_hi:[1,0]
  v_pk_mul_f32 v[112:113], v[112:113], v[18:19] op_sel_hi:[1,0]
  v_pk_mul_f32 v[114:115], v[114:115], v[18:19] op_sel_hi:[1,0]
  v_pk_add_f32 v[108:109], v[108:109], v[156:157]
  v_pk_add_f32 v[110:111], v[110:111], v[158:159]
  v_pk_add_f32 v[112:113], v[112:113], v[160:161]
  v_pk_add_f32 v[114:115], v[114:115], v[162:163]
  v_cvt_pk_bf16_f32 v76, v108, v109
  v_cvt_pk_bf16_f32 v77, v110, v111
  ds_write_b64 v28, v[76:77]
  v_cvt_pk_bf16_f32 v78, v112, v113
  v_cvt_pk_bf16_f32 v79, v114, v115
  ds_write_b64 v29, v[78:79]
  v_and_b32 v116, s39, v116
  v_and_b32 v117, s39, v117
  v_and_b32 v118, s39, v118
  v_and_b32 v119, s39, v119
  v_and_b32 v120, s39, v120
  v_and_b32 v121, s39, v121
  v_and_b32 v122, s39, v122
  v_and_b32 v123, s39, v123
  v_pk_mul_f32 v[116:117], v[116:117], v[18:19] op_sel_hi:[1,0]
  v_pk_mul_f32 v[118:119], v[118:119], v[18:19] op_sel_hi:[1,0]
  v_pk_mul_f32 v[120:121], v[120:121], v[18:19] op_sel_hi:[1,0]
  v_pk_mul_f32 v[122:123], v[122:123], v[18:19] op_sel_hi:[1,0]
  v_pk_add_f32 v[116:117], v[116:117], v[164:165]
  v_pk_add_f32 v[118:119], v[118:119], v[166:167]
  v_pk_add_f32 v[120:121], v[120:121], v[168:169]
  v_pk_add_f32 v[122:123], v[122:123], v[170:171]
  v_cvt_pk_bf16_f32 v80, v116, v117
  v_cvt_pk_bf16_f32 v81, v118, v119
  ds_write_b64 v30, v[80:81]
  v_cvt_pk_bf16_f32 v82, v120, v121
  v_cvt_pk_bf16_f32 v83, v122, v123
  ds_write_b64 v31, v[82:83]
  s_waitcnt lgkmcnt(0)
  s_barrier
  ds_read_b128 v[76:79], v32
  ds_read_b128 v[80:83], v33 offset:1024
  s_waitcnt lgkmcnt(1)
  buffer_store_dwordx4 v[76:79], v27, s[16:19], 0 offen sc1
  s_waitcnt lgkmcnt(0)
  buffer_store_dwordx4 v[80:83], v27, s[16:19], 0 offen offset:1024 sc1
L_done:
  s_endpgm
.section .rodata,"a"
.p2align 6
.amdhsa_kernel standalone__gqa_softmax__sampling_kernel
  .amdhsa_next_free_vgpr 200
  .amdhsa_next_free_sgpr 44
  .amdhsa_accum_offset 200
  .amdhsa_group_segment_fixed_size 0
  .amdhsa_kernarg_size 48
  .amdhsa_user_sgpr_count 2
  .amdhsa_user_sgpr_kernarg_segment_ptr 1
  .amdhsa_system_sgpr_workgroup_id_x 1
.end_amdhsa_kernel
```
